```python
import torch

def _softmax(x, axis=-1):
    return torch.softmax(x, dim=axis)
def _gelu(x):
    return torch.nn.functional.gelu(x, approximate="tanh")
def _silu(x):
    return torch.nn.functional.silu(x)
def _sigmoid(x):
    return torch.sigmoid(x)
def _layernorm(x, axis=-1, eps=1e-5):
    m = x.mean(dim=axis, keepdim=True)
    v = x.var(dim=axis, keepdim=True, unbiased=False)
    return (x - m) / torch.sqrt(v + eps)
def _scatter_add(tgt, idx, src, axis=0):
    return tgt.clone().index_add_(axis, idx, src)
def _segment_sum(src, seg, n):
    out = torch.zeros((n,) + src.shape[1:], dtype=src.dtype)
    return out.index_add_(0, seg, src)
def _pad(x, pw):
    flat = tuple(v for pair in reversed(pw) for v in pair)
    return torch.nn.functional.pad(x, flat)

kernel_name = 'standalone__structured_sparse_n_m__ragged'

def setup_inputs():

    _w = (lambda a: (lambda t: t.to(torch.bfloat16) if t.is_floating_point() else t)(torch.as_tensor(a)))
    B, S, D = 4, 2048, 576
    assert D % 4 == 0, "d_model must be divisible by M=4 for 2:4 sparsity"
    return {
        "x": _w((lambda *s: torch.randn(*s, dtype=torch.bfloat16) * 0.05)(B, S, D)),
        "w": _w((lambda *s: torch.randn(*s, dtype=torch.bfloat16) * 0.05)(D, D)),
        "b": _w((lambda *s: torch.randn(*s, dtype=torch.bfloat16) * 0.05)(D)),
    }

def reference(x, w, b):
    B, S, D = x.shape
    N, M = 2, 4
    G = D // M
    wg = w.reshape(G, M, D)
    mag = torch.abs(wg)
    order = torch.argsort(mag, 1)
    thr = (lambda x, i, axis: torch.take_along_dim(x, i, dim=axis))(mag, order[:, M - N:M - N + 1, :], 1)
    mask = (lambda x, dt: x.to(dt))(mag >= thr, w.dtype)
    wp = (wg * mask).reshape(D, D)
    return torch.einsum("bsd,df->bsf", x, wp) + b
```

```asm
; @launch grid=(256,1,1) block=(384,1,1) lds=163840
.amdgcn_target "amdgcn-amd-amdhsa--gfx950"
.text
.globl standalone__structured_sparse_n_m__ragged_kernel
.p2align 8
.type standalone__structured_sparse_n_m__ragged_kernel,@function
standalone__structured_sparse_n_m__ragged_kernel:
    s_load_dwordx8 s[4:11], s[0:1], 0
    s_cmp_ge_u32 s2, 256
    s_cbranch_scc1 L_exit
    v_lshrrev_b32 v1, 6, v0
    v_and_b32 v2, 63, v0
    v_readfirstlane_b32 s3, v1
    s_and_b32 s30, s2, 7
    s_lshr_b32 s31, s2, 3
    s_mul_i32 s32, s31, 37
    s_lshr_b32 s32, s32, 8
    s_mul_i32 s33, s32, 7
    s_sub_u32 s33, s31, s33
    s_lshl_b32 s36, s32, 8
    s_mul_i32 s35, s33, 160
    s_movk_i32 s34, 160
    s_lshl_b32 s37, s33, 7
    s_add_u32 s37, s37, 128
    s_cmp_ge_u32 s33, 4
    s_cselect_b32 s35, s37, s35
    s_cselect_b32 s34, 128, s34
    s_lshl_b32 s37, s33, 8
    s_cmp_eq_u32 s32, 4
    s_cselect_b32 s35, s37, s35
    s_cselect_b32 s34, 256, s34
    s_cselect_b32 s38, 1, 0
    s_lshl_b32 s30, s30, 10
    s_add_u32 s35, s35, s30
    s_mul_i32 s37, s35, 1152
    s_mov_b32 s57, s37
    s_lshl_b32 s39, s34, 7
    s_lshl_b32 s40, s39, 2
    s_lshr_b32 s41, 16384, s38
    s_cmp_ge_u32 s3, 2
    s_cbranch_scc1 L_compute
    s_mov_b32 s50, 0
    s_mov_b32 s51, 0
    v_lshrrev_b32 v6, 4, v2
    v_lshrrev_b32 v7, 2, v2
    v_sub_u32 v7, v7, v6
    v_and_b32 v7, 3, v7
    v_mul_u32_u24 v19, 1152, v6
    v_and_b32 v8, 3, v2
    v_lshl_add_u32 v19, v8, 4, v19
    v_lshlrev_b32 v8, 6, v7
    v_lshrrev_b32 v9, 1, v7
    v_mul_u32_u24 v9, 36864, v9
    v_and_b32 v10, 1, v7
    v_lshl_add_u32 v9, v10, 6, v9
    v_sub_u32 v9, v9, v8
    v_mul_lo_u32 v9, v9, s38
    v_add3_u32 v19, v19, v8, v9
    v_lshrrev_b32 v7, 3, v2
    v_and_b32 v8, 7, v2
    v_xor_b32 v8, v8, v6
    v_mul_u32_u24 v17, 1152, v7
    v_add_u32 v18, 9216, v17
    v_lshl_add_u32 v17, v8, 4, v17
    v_xor_b32 v8, 4, v8
    v_lshl_add_u32 v18, v8, 4, v18
    s_lshr_b32 s62, 4, s38
    s_mul_i32 s62, s62, s3
    s_lshr_b32 s63, s34, 5
    s_min_u32 s63, s63, 5
    s_mul_i32 s64, s38, 3
    s_cmp_eq_u32 s3, 0
    s_cselect_b32 s63, s63, s64
    s_add_u32 s42, s62, s63
    s_mul_i32 s64, s3, 184320
    s_add_u32 s64, s64, s37
    s_mul_i32 s52, s3, 20480
    s_add_u32 s65, s52, s40
    s_mov_b32 s66, s40
    s_lshl_b32 s46, s41, 2
    s_add_u32 s46, s46, s40
    s_waitcnt lgkmcnt(0)
    s_mov_b32 s16, s4
    s_mov_b32 s17, s5
    s_mov_b32 s18, 9437184
    s_mov_b32 s19, 0x20000
    s_mov_b32 s12, s6
    s_mov_b32 s13, s7
    s_mov_b32 s14, 663552
    s_mov_b32 s15, 0x20000
L_lissue:
    s_cmp_eq_u32 s62, 0
    s_cbranch_scc1 L_xl
    s_mul_i32 s43, s50, 73728
    s_add_u32 s43, s43, s36
    s_mov_b32 m0, s66
    s_mov_b32 s44, s62
L_wl4:
    buffer_load_dwordx4 v19, s[12:15], s43 offen lds
    s_add_u32 m0, m0, 1024
    s_add_u32 s43, s43, 4608
    buffer_load_dwordx4 v19, s[12:15], s43 offen lds
    s_add_u32 m0, m0, 1024
    s_add_u32 s43, s43, 4608
    buffer_load_dwordx4 v19, s[12:15], s43 offen lds
    s_add_u32 m0, m0, 1024
    s_add_u32 s43, s43, 4608
    buffer_load_dwordx4 v19, s[12:15], s43 offen lds
    s_add_u32 m0, m0, 1024
    s_add_u32 s43, s43, 4608
    s_sub_u32 s44, s44, 1
    s_cmp_lg_u32 s44, 0
    s_cbranch_scc1 L_wl4
    s_add_u32 s66, s66, s41
    s_cmp_eq_u32 s66, s46
    s_cselect_b32 s66, s40, s66
    s_cmp_eq_u32 s63, 0
    s_cbranch_scc1 L_lcommon
L_xl:
    s_lshl_b32 s43, s50, 7
    s_add_u32 s43, s43, s64
    s_mov_b32 m0, s52
    s_mov_b32 s44, s63
L_xl4:
    s_add_u32 s45, s43, 18432
    buffer_load_dwordx4 v17, s[16:19], s43 offen lds
    s_add_u32 m0, m0, 1024
    s_nop 0
    buffer_load_dwordx4 v18, s[16:19], s43 offen lds
    s_add_u32 m0, m0, 1024
    s_nop 0
    buffer_load_dwordx4 v17, s[16:19], s45 offen lds
    s_add_u32 m0, m0, 1024
    s_nop 0
    buffer_load_dwordx4 v18, s[16:19], s45 offen lds
    s_add_u32 m0, m0, 1024
    s_add_u32 s43, s43, 36864
    s_sub_u32 s44, s44, 1
    s_cmp_lg_u32 s44, 0
    s_cbranch_scc1 L_xl4
    s_add_u32 s52, s52, s39
    s_cmp_eq_u32 s52, s65
    s_cselect_b32 s45, s40, 0
    s_sub_u32 s52, s52, s45
L_lcommon:
    s_add_u32 s50, s50, 1
    s_cmp_lt_u32 s50, 2
    s_cbranch_scc1 L_lissue
L_lb:
    s_sub_u32 s53, s50, s51
    s_sub_u32 s53, s53, 1
    s_mul_i32 s53, s53, s42
    s_cmp_eq_u32 s53, 5
    s_cbranch_scc1 L_lw5
    s_cmp_eq_u32 s53, 4
    s_cbranch_scc1 L_lw4
    s_waitcnt vmcnt(0)
L_lw4:
    s_waitcnt vmcnt(16)
L_lw5:
    s_waitcnt vmcnt(20)
    s_barrier
    s_add_u32 s51, s51, 1
    s_cmp_eq_u32 s51, 9
    s_cbranch_scc1 L_lexit
    s_cmp_eq_u32 s51, 8
    s_cbranch_scc1 L_lzero
    s_cmp_ge_u32 s50, 9
    s_cbranch_scc1 L_lb
    s_branch L_lissue
L_lzero:
    s_add_u32 s47, s40, s41
    v_mov_b32 v21, s47
    v_mov_b32 v4, 0
    v_mov_b32 v5, 0
    v_mov_b32 v6, 0
    v_mov_b32 v7, 0
    ds_write_b128 v21, v[4:7]
    s_waitcnt lgkmcnt(0)
    s_branch L_lb
L_lexit:
    s_add_u32 s47, s40, s41
    v_mov_b32 v21, s47
    s_mov_b32 s24, s10
    s_mov_b32 s25, s11
    s_mov_b32 s26, 9437184
    s_mov_b32 s27, 0x20000
    v_lshrrev_b32 v10, 4, v2
    v_and_b32 v13, 15, v2
    s_lshl_b32 s48, s3, 4
    s_mul_i32 s47, s48, 272
    s_add_u32 s47, s47, s39
    v_mul_u32_u24 v20, 272, v10
    v_lshl_add_u32 v20, v13, 4, v20
    v_add_u32 v20, s47, v20
    v_mul_u32_u24 v22, 1152, v10
    v_lshl_add_u32 v22, v13, 4, v22
    v_lshrrev_b32 v9, 3, v13
    s_mul_i32 s47, s38, 147328
    v_mul_lo_u32 v9, v9, s47
    v_add_u32 v22, v22, v9
    s_mul_i32 s46, s48, 1152
    s_add_u32 s46, s46, s57
    s_add_u32 s46, s46, s36
    s_lshr_b32 s49, s34, s38
    s_lshr_b32 s49, s49, 5
    s_mov_b32 s48, 0
    s_lshl_b32 s52, s41, 1
    s_add_u32 s52, s52, s40
    s_sub_u32 s52, s52, s39
    s_sub_u32 s52, s52, 17408
L_spoll:
    s_sleep 1
    ds_read_b128 v[4:7], v21
    s_waitcnt lgkmcnt(0)
    v_min_u32 v4, v4, v5
    v_min3_u32 v4, v4, v6, v7
    s_nop 0
    v_readfirstlane_b32 s47, v4
    s_cmp_le_u32 s47, s48
    s_cbranch_scc1 L_spoll
    ds_read_b128 v[24:27], v20 offset:0
    ds_read_b128 v[28:31], v20 offset:1088
    ds_read_b128 v[32:35], v20 offset:2176
    ds_read_b128 v[36:39], v20 offset:3264
    s_cmp_eq_u32 s48, 2
    s_cselect_b32 s47, s52, 8704
    v_add_u32 v20, s47, v20
    s_waitcnt lgkmcnt(3)
    s_add_u32 s47, s46, 0
    buffer_store_dwordx4 v[24:27], v22, s[24:27], s47 offen sc0 sc1
    s_waitcnt lgkmcnt(2)
    s_add_u32 s47, s46, 4608
    buffer_store_dwordx4 v[28:31], v22, s[24:27], s47 offen sc0 sc1
    s_waitcnt lgkmcnt(1)
    s_add_u32 s47, s46, 9216
    buffer_store_dwordx4 v[32:35], v22, s[24:27], s47 offen sc0 sc1
    s_waitcnt lgkmcnt(0)
    s_add_u32 s47, s46, 13824
    buffer_store_dwordx4 v[36:39], v22, s[24:27], s47 offen sc0 sc1
    s_add_u32 s46, s46, 36864
    s_add_u32 s48, s48, 1
    s_cmp_lt_u32 s48, s49
    s_cbranch_scc1 L_spoll
    s_endpgm
L_compute:
    s_sub_u32 s51, s3, 2
    s_lshr_b32 s42, s51, 1
    s_mul_i32 s42, s42, s38
    s_lshl_b32 s43, s42, 1
    s_sub_u32 s43, s51, s43
    s_lshl_b32 s44, s43, 6
    s_add_u32 s44, s44, s36
    v_and_b32 v11, 31, v2
    v_lshrrev_b32 v12, 5, v2
    v_and_b32 v8, 19, v11
    v_and_b32 v9, 4, v11
    v_lshl_add_u32 v8, v9, 1, v8
    v_and_b32 v9, 8, v11
    v_lshrrev_b32 v9, 1, v9
    v_add_u32 v8, v8, v9
    v_lshlrev_b32 v8, 1, v8
    v_lshl_add_u32 v8, v12, 16, v8
    s_waitcnt lgkmcnt(0)
    s_mov_b32 s20, s8
    s_mov_b32 s21, s9
    s_mov_b32 s22, 1152
    s_mov_b32 s23, 0x20000
    buffer_load_ushort v24, v8, s[20:23], s44 offen
    s_mov_b32 s24, s10
    s_mov_b32 s25, s11
    s_mov_b32 s26, 9437184
    s_mov_b32 s27, 0x20000
    s_mov_b32 s50, 0
    s_mov_b32 s45, 0x80008000
    v_lshrrev_b32 v10, 4, v2
    v_and_b32 v13, 15, v2
    s_lshl_b32 s46, s42, 14
    v_lshrrev_b32 v14, 1, v11
    v_and_b32 v14, 7, v14
    v_lshlrev_b32 v15, 7, v11
    v_add_u32 v15, s46, v15
    v_xor_b32 v14, v12, v14
    v_lshl_add_u32 v3, v14, 4, v15
    v_xor_b32 v4, 32, v3
    v_xor_b32 v5, 64, v3
    v_xor_b32 v6, 96, v3
    v_lshrrev_b32 v14, 2, v13
    v_lshl_add_u32 v15, v12, 3, v14
    v_lshlrev_b32 v15, 8, v15
    v_add_u32 v15, s40, v15
    v_and_b32 v9, 1, v2
    v_lshl_add_u32 v15, v9, 4, v15
    v_and_b32 v9, 2, v2
    v_lshl_add_u32 v15, v9, 2, v15
    v_and_b32 v9, 1, v10
    v_lshl_add_u32 v15, v9, 5, v15
    s_mov_b32 s47, s43
    s_movk_i32 s48, 0
    v_add_u32 v9, s47, v14
    v_and_b32 v9, 3, v9
    v_lshl_add_u32 v16, v9, 6, v15
    v_add_u32 v16, s48, v16
    s_mov_b32 s47, s43
    s_movk_i32 s48, 4096
    v_add_u32 v9, s47, v14
    v_and_b32 v9, 3, v9
    v_lshl_add_u32 v17, v9, 6, v15
    v_add_u32 v17, s48, v17
    s_lshl_b32 s47, s38, 1
    s_add_u32 s47, s47, s43
    s_lshl_b32 s48, s38, 13
    s_sub_u32 s48, 8192, s48
    v_add_u32 v9, s47, v14
    v_and_b32 v9, 3, v9
    v_lshl_add_u32 v18, v9, 6, v15
    v_add_u32 v18, s48, v18
    s_lshl_b32 s47, s38, 1
    s_add_u32 s47, s47, s43
    s_lshl_b32 s48, s38, 13
    s_sub_u32 s48, 12288, s48
    v_add_u32 v9, s47, v14
    v_and_b32 v9, 3, v9
    v_lshl_add_u32 v19, v9, 6, v15
    v_add_u32 v19, s48, v19
    s_lshl_b32 s47, s51, 6
    s_add_u32 s47, s47, s39
    v_mul_u32_u24 v20, 272, v11
    v_lshl_add_u32 v20, v12, 4, v20
    v_add_u32 v20, s47, v20
    s_lshl_b32 s47, s51, 2
    s_add_u32 s47, s47, s40
    s_add_u32 s47, s47, s41
    v_mov_b32 v21, s47
    s_lshl_b32 s47, s41, 1
    s_add_u32 s47, s47, s40
    s_sub_u32 s47, s47, s39
    v_add_u32 v23, s47, v20
    s_mul_i32 s54, s39, -3
    s_mul_i32 s55, s41, -3
    s_mov_b32 s56, 0
    v_mov_b32 v28, 0x3f80
    v_mov_b32 v25, 0
    v_mov_b32 v26, 0
    v_mov_b32 v27, 0
    v_mov_b32 v29, 0
    v_mov_b32 v30, 0
    v_mov_b32 v31, 0
    s_nop 1
    s_waitcnt vmcnt(0)
    v_mfma_f32_32x32x16_bf16 v[96:111], v[24:27], v[28:31], 0
    v_mfma_f32_32x32x16_bf16 v[112:127], v[24:27], v[28:31], 0
    v_mfma_f32_32x32x16_bf16 v[128:143], v[24:27], v[28:31], 0
    v_mfma_f32_32x32x16_bf16 v[144:159], v[24:27], v[28:31], 0
    v_mfma_f32_32x32x16_bf16 v[160:175], v[24:27], v[28:31], 0
    s_barrier
    s_cmp_eq_u32 s34, 160
    s_cbranch_scc0 L_c4_start
L_c5_start:
    ds_read_b64_tr_b16 v[24:25], v16
    ds_read_b64_tr_b16 v[26:27], v16 offset:1024
    ds_read_b64_tr_b16 v[28:29], v17
    ds_read_b64_tr_b16 v[30:31], v17 offset:1024
    ds_read_b128 v[56:59], v3 offset:0
    ds_read_b128 v[60:63], v3 offset:4096
    ds_read_b128 v[64:67], v3 offset:8192
    ds_read_b128 v[68:71], v3 offset:12288
    ds_read_b128 v[72:75], v3 offset:16384
    s_waitcnt lgkmcnt(7)
    v_or_b32 v40, s45, v24
    v_or_b32 v41, s45, v25
    v_or_b32 v42, s45, v26
    v_or_b32 v43, s45, v27
    v_pk_max_u16 v44, v40, v41
    v_pk_max_u16 v45, v42, v43
    v_pk_min_u16 v46, v40, v41
    v_pk_min_u16 v47, v42, v43
    v_pk_min_u16 v44, v44, v44 op_sel:[0,1] op_sel_hi:[1,0]
    v_pk_min_u16 v45, v45, v45 op_sel:[0,1] op_sel_hi:[1,0]
    v_pk_max_u16 v46, v46, v46 op_sel:[0,1] op_sel_hi:[1,0]
    v_pk_max_u16 v47, v47, v47 op_sel:[0,1] op_sel_hi:[1,0]
    v_pk_max_u16 v44, v44, v46
    v_pk_max_u16 v45, v45, v47
    v_pk_sub_i16 v40, v40, v44
    v_pk_sub_i16 v41, v41, v44
    v_pk_sub_i16 v42, v42, v45
    v_pk_sub_i16 v43, v43, v45
    v_pk_ashrrev_i16 v40, 15, v40 op_sel_hi:[0,1]
    v_pk_ashrrev_i16 v41, 15, v41 op_sel_hi:[0,1]
    v_pk_ashrrev_i16 v42, 15, v42 op_sel_hi:[0,1]
    v_pk_ashrrev_i16 v43, 15, v43 op_sel_hi:[0,1]
    v_bfi_b32 v32, v40, 0, v24
    v_bfi_b32 v33, v41, 0, v25
    v_bfi_b32 v34, v42, 0, v26
    v_bfi_b32 v35, v43, 0, v27
L_c5_loop:
    s_waitcnt lgkmcnt(3)
    s_nop 0
    v_mfma_f32_32x32x16_bf16 v[96:111], v[32:35], v[56:59], v[96:111]
    ds_read_b64_tr_b16 v[24:25], v18
    ds_read_b64_tr_b16 v[26:27], v18 offset:1024
    ds_read_b128 v[76:79], v4 offset:0
    ds_read_b128 v[80:83], v4 offset:4096
    ds_read_b128 v[84:87], v4 offset:8192
    ds_read_b128 v[88:91], v4 offset:12288
    ds_read_b128 v[92:95], v4 offset:16384
    v_mfma_f32_32x32x16_bf16 v[112:127], v[32:35], v[60:63], v[112:127]
    v_or_b32 v40, s45, v28
    v_or_b32 v41, s45, v29
    v_or_b32 v42, s45, v30
    v_or_b32 v43, s45, v31
    v_pk_max_u16 v44, v40, v41
    v_pk_max_u16 v45, v42, v43
    v_pk_min_u16 v46, v40, v41
    s_waitcnt lgkmcnt(7)
    v_mfma_f32_32x32x16_bf16 v[128:143], v[32:35], v[64:67], v[128:143]
    v_pk_min_u16 v47, v42, v43
    v_pk_min_u16 v44, v44, v44 op_sel:[0,1] op_sel_hi:[1,0]
    v_pk_min_u16 v45, v45, v45 op_sel:[0,1] op_sel_hi:[1,0]
    v_pk_max_u16 v46, v46, v46 op_sel:[0,1] op_sel_hi:[1,0]
    v_pk_max_u16 v47, v47, v47 op_sel:[0,1] op_sel_hi:[1,0]
    v_pk_max_u16 v44, v44, v46
    v_mfma_f32_32x32x16_bf16 v[144:159], v[32:35], v[68:71], v[144:159]
    v_pk_max_u16 v45, v45, v47
    v_pk_sub_i16 v40, v40, v44
    v_pk_sub_i16 v41, v41, v44
    v_pk_sub_i16 v42, v42, v45
    v_pk_sub_i16 v43, v43, v45
    v_pk_ashrrev_i16 v40, 15, v40 op_sel_hi:[0,1]
    v_pk_ashrrev_i16 v41, 15, v41 op_sel_hi:[0,1]
    v_mfma_f32_32x32x16_bf16 v[160:175], v[32:35], v[72:75], v[160:175]
    v_pk_ashrrev_i16 v42, 15, v42 op_sel_hi:[0,1]
    v_pk_ashrrev_i16 v43, 15, v43 op_sel_hi:[0,1]
    v_bfi_b32 v36, v40, 0, v28
    v_bfi_b32 v37, v41, 0, v29
    v_bfi_b32 v38, v42, 0, v30
    v_bfi_b32 v39, v43, 0, v31
    s_waitcnt lgkmcnt(3)
    s_nop 0
    v_mfma_f32_32x32x16_bf16 v[96:111], v[36:39], v[76:79], v[96:111]
    ds_read_b64_tr_b16 v[28:29], v19
    ds_read_b64_tr_b16 v[30:31], v19 offset:1024
    ds_read_b128 v[56:59], v5 offset:0
    ds_read_b128 v[60:63], v5 offset:4096
    ds_read_b128 v[64:67], v5 offset:8192
    ds_read_b128 v[68:71], v5 offset:12288
    ds_read_b128 v[72:75], v5 offset:16384
    v_mfma_f32_32x32x16_bf16 v[112:127], v[36:39], v[80:83], v[112:127]
    v_or_b32 v40, s45, v24
    v_or_b32 v41, s45, v25
    v_or_b32 v42, s45, v26
    v_or_b32 v43, s45, v27
    v_pk_max_u16 v44, v40, v41
    v_pk_max_u16 v45, v42, v43
    v_pk_min_u16 v46, v40, v41
    s_waitcnt lgkmcnt(7)
    v_mfma_f32_32x32x16_bf16 v[128:143], v[36:39], v[84:87], v[128:143]
    v_pk_min_u16 v47, v42, v43
    v_pk_min_u16 v44, v44, v44 op_sel:[0,1] op_sel_hi:[1,0]
    v_pk_min_u16 v45, v45, v45 op_sel:[0,1] op_sel_hi:[1,0]
    v_pk_max_u16 v46, v46, v46 op_sel:[0,1] op_sel_hi:[1,0]
    v_pk_max_u16 v47, v47, v47 op_sel:[0,1] op_sel_hi:[1,0]
    v_pk_max_u16 v44, v44, v46
    v_mfma_f32_32x32x16_bf16 v[144:159], v[36:39], v[88:91], v[144:159]
    v_pk_max_u16 v45, v45, v47
    v_pk_sub_i16 v40, v40, v44
    v_pk_sub_i16 v41, v41, v44
    v_pk_sub_i16 v42, v42, v45
    v_pk_sub_i16 v43, v43, v45
    v_pk_ashrrev_i16 v40, 15, v40 op_sel_hi:[0,1]
    v_pk_ashrrev_i16 v41, 15, v41 op_sel_hi:[0,1]
    v_mfma_f32_32x32x16_bf16 v[160:175], v[36:39], v[92:95], v[160:175]
    v_pk_ashrrev_i16 v42, 15, v42 op_sel_hi:[0,1]
    v_pk_ashrrev_i16 v43, 15, v43 op_sel_hi:[0,1]
    v_bfi_b32 v32, v40, 0, v24
    v_bfi_b32 v33, v41, 0, v25
    v_bfi_b32 v34, v42, 0, v26
    v_bfi_b32 v35, v43, 0, v27
    s_waitcnt lgkmcnt(3)
    s_nop 0
    v_mfma_f32_32x32x16_bf16 v[96:111], v[32:35], v[56:59], v[96:111]
    s_add_u32 s56, s56, 1
    s_cmp_eq_u32 s56, 4
    s_cselect_b32 s58, s54, s39
    s_cselect_b32 s59, s55, s41
    s_cselect_b32 s56, 0, s56
    s_barrier
    v_add_u32 v16, s59, v16
    v_add_u32 v17, s59, v17
    v_add_u32 v18, s59, v18
    v_add_u32 v19, s59, v19
    ds_read_b64_tr_b16 v[24:25], v16
    ds_read_b64_tr_b16 v[26:27], v16 offset:1024
    v_mfma_f32_32x32x16_bf16 v[112:127], v[32:35], v[60:63], v[112:127]
    ds_read_b128 v[76:79], v6 offset:0
    ds_read_b128 v[80:83], v6 offset:4096
    ds_read_b128 v[84:87], v6 offset:8192
    ds_read_b128 v[88:91], v6 offset:12288
    ds_read_b128 v[92:95], v6 offset:16384
    v_or_b32 v40, s45, v28
    v_or_b32 v41, s45, v29
    v_or_b32 v42, s45, v30
    s_waitcnt lgkmcnt(7)
    v_mfma_f32_32x32x16_bf16 v[128:143], v[32:35], v[64:67], v[128:143]
    v_or_b32 v43, s45, v31
    v_pk_max_u16 v44, v40, v41
    v_pk_max_u16 v45, v42, v43
    v_pk_min_u16 v46, v40, v41
    v_pk_min_u16 v47, v42, v43
    v_pk_min_u16 v44, v44, v44 op_sel:[0,1] op_sel_hi:[1,0]
    v_pk_min_u16 v45, v45, v45 op_sel:[0,1] op_sel_hi:[1,0]
    v_pk_max_u16 v46, v46, v46 op_sel:[0,1] op_sel_hi:[1,0]
    v_mfma_f32_32x32x16_bf16 v[144:159], v[32:35], v[68:71], v[144:159]
    v_pk_max_u16 v47, v47, v47 op_sel:[0,1] op_sel_hi:[1,0]
    v_pk_max_u16 v44, v44, v46
    v_pk_max_u16 v45, v45, v47
    v_pk_sub_i16 v40, v40, v44
    v_pk_sub_i16 v41, v41, v44
    v_pk_sub_i16 v42, v42, v45
    v_pk_sub_i16 v43, v43, v45
    v_pk_ashrrev_i16 v40, 15, v40 op_sel_hi:[0,1]
    v_mfma_f32_32x32x16_bf16 v[160:175], v[32:35], v[72:75], v[160:175]
    v_pk_ashrrev_i16 v41, 15, v41 op_sel_hi:[0,1]
    v_pk_ashrrev_i16 v42, 15, v42 op_sel_hi:[0,1]
    v_pk_ashrrev_i16 v43, 15, v43 op_sel_hi:[0,1]
    v_bfi_b32 v36, v40, 0, v28
    v_bfi_b32 v37, v41, 0, v29
    v_bfi_b32 v38, v42, 0, v30
    v_bfi_b32 v39, v43, 0, v31
    s_waitcnt lgkmcnt(3)
    s_nop 0
    v_mfma_f32_32x32x16_bf16 v[96:111], v[36:39], v[76:79], v[96:111]
    v_add_u32 v3, s58, v3
    v_add_u32 v4, s58, v4
    v_add_u32 v5, s58, v5
    v_add_u32 v6, s58, v6
    ds_read_b64_tr_b16 v[28:29], v17
    ds_read_b64_tr_b16 v[30:31], v17 offset:1024
    ds_read_b128 v[56:59], v3 offset:0
    ds_read_b128 v[60:63], v3 offset:4096
    v_mfma_f32_32x32x16_bf16 v[112:127], v[36:39], v[80:83], v[112:127]
    ds_read_b128 v[64:67], v3 offset:8192
    ds_read_b128 v[68:71], v3 offset:12288
    ds_read_b128 v[72:75], v3 offset:16384
    v_or_b32 v40, s45, v24
    v_or_b32 v41, s45, v25
    v_or_b32 v42, s45, v26
    v_or_b32 v43, s45, v27
    s_waitcnt lgkmcnt(7)
    v_mfma_f32_32x32x16_bf16 v[128:143], v[36:39], v[84:87], v[128:143]
    v_pk_max_u16 v44, v40, v41
    v_pk_max_u16 v45, v42, v43
    v_pk_min_u16 v46, v40, v41
    v_pk_min_u16 v47, v42, v43
    v_pk_min_u16 v44, v44, v44 op_sel:[0,1] op_sel_hi:[1,0]
    v_pk_min_u16 v45, v45, v45 op_sel:[0,1] op_sel_hi:[1,0]
    v_pk_max_u16 v46, v46, v46 op_sel:[0,1] op_sel_hi:[1,0]
    v_pk_max_u16 v47, v47, v47 op_sel:[0,1] op_sel_hi:[1,0]
    v_mfma_f32_32x32x16_bf16 v[144:159], v[36:39], v[88:91], v[144:159]
    v_pk_max_u16 v44, v44, v46
    v_pk_max_u16 v45, v45, v47
    v_pk_sub_i16 v40, v40, v44
    v_pk_sub_i16 v41, v41, v44
    v_pk_sub_i16 v42, v42, v45
    v_pk_sub_i16 v43, v43, v45
    v_pk_ashrrev_i16 v40, 15, v40 op_sel_hi:[0,1]
    v_mfma_f32_32x32x16_bf16 v[160:175], v[36:39], v[92:95], v[160:175]
    v_pk_ashrrev_i16 v41, 15, v41 op_sel_hi:[0,1]
    v_pk_ashrrev_i16 v42, 15, v42 op_sel_hi:[0,1]
    v_pk_ashrrev_i16 v43, 15, v43 op_sel_hi:[0,1]
    v_bfi_b32 v32, v40, 0, v24
    v_bfi_b32 v33, v41, 0, v25
    v_bfi_b32 v34, v42, 0, v26
    v_bfi_b32 v35, v43, 0, v27
    s_add_u32 s50, s50, 1
    s_cmp_lt_u32 s50, 8
    s_cbranch_scc1 L_c5_loop
L_c5_p0:
    s_waitcnt lgkmcnt(4)
    v_mfma_f32_32x32x16_bf16 v[96:111], v[32:35], v[56:59], v[96:111]
    ds_read_b128 v[76:79], v4 offset:0
    ds_read_b128 v[80:83], v4 offset:4096
    ds_read_b64_tr_b16 v[24:25], v18
    ds_read_b64_tr_b16 v[26:27], v18 offset:1024
    v_or_b32 v40, s45, v28
    v_or_b32 v41, s45, v29
    v_or_b32 v42, s45, v30
    v_or_b32 v43, s45, v31
    v_pk_max_u16 v44, v40, v41
    v_pk_max_u16 v45, v42, v43
    v_pk_min_u16 v46, v40, v41
    v_pk_min_u16 v47, v42, v43
    v_pk_min_u16 v44, v44, v44 op_sel:[0,1] op_sel_hi:[1,0]
    v_pk_min_u16 v45, v45, v45 op_sel:[0,1] op_sel_hi:[1,0]
    v_pk_max_u16 v46, v46, v46 op_sel:[0,1] op_sel_hi:[1,0]
    v_pk_max_u16 v47, v47, v47 op_sel:[0,1] op_sel_hi:[1,0]
    s_waitcnt lgkmcnt(7)
    v_mfma_f32_32x32x16_bf16 v[112:127], v[32:35], v[60:63], v[112:127]
    ds_read_b128 v[84:87], v5 offset:0
    ds_read_b128 v[88:91], v5 offset:4096
    v_pk_max_u16 v44, v44, v46
    v_pk_max_u16 v45, v45, v47
    v_pk_sub_i16 v40, v40, v44
    v_pk_sub_i16 v41, v41, v44
    v_pk_sub_i16 v42, v42, v45
    v_pk_sub_i16 v43, v43, v45
    v_pk_ashrrev_i16 v40, 15, v40 op_sel_hi:[0,1]
    v_pk_ashrrev_i16 v41, 15, v41 op_sel_hi:[0,1]
    v_pk_ashrrev_i16 v42, 15, v42 op_sel_hi:[0,1]
    v_pk_ashrrev_i16 v43, 15, v43 op_sel_hi:[0,1]
    v_bfi_b32 v36, v40, 0, v28
    v_bfi_b32 v37, v41, 0, v29
    v_bfi_b32 v38, v42, 0, v30
    v_bfi_b32 v39, v43, 0, v31
    s_waitcnt lgkmcnt(5)
    s_nop 1
    v_mfma_f32_32x32x16_bf16 v[96:111], v[36:39], v[76:79], v[96:111]
    ds_read_b128 v[92:95], v6 offset:0
    ds_read_b128 v[56:59], v6 offset:4096
    ds_read_b64_tr_b16 v[28:29], v19
    ds_read_b64_tr_b16 v[30:31], v19 offset:1024
    s_waitcnt lgkmcnt(6)
    v_or_b32 v40, s45, v24
    v_or_b32 v41, s45, v25
    v_or_b32 v42, s45, v26
    v_or_b32 v43, s45, v27
    v_pk_max_u16 v44, v40, v41
    v_pk_max_u16 v45, v42, v43
    v_pk_min_u16 v46, v40, v41
    v_pk_min_u16 v47, v42, v43
    v_pk_min_u16 v44, v44, v44 op_sel:[0,1] op_sel_hi:[1,0]
    v_pk_min_u16 v45, v45, v45 op_sel:[0,1] op_sel_hi:[1,0]
    v_pk_max_u16 v46, v46, v46 op_sel:[0,1] op_sel_hi:[1,0]
    v_pk_max_u16 v47, v47, v47 op_sel:[0,1] op_sel_hi:[1,0]
    v_mfma_f32_32x32x16_bf16 v[112:127], v[36:39], v[80:83], v[112:127]
    ds_read_b128 v[60:63], v4 offset:8192
    ds_read_b128 v[76:79], v5 offset:8192
    v_pk_max_u16 v44, v44, v46
    v_pk_max_u16 v45, v45, v47
    v_pk_sub_i16 v40, v40, v44
    v_pk_sub_i16 v41, v41, v44
    v_pk_sub_i16 v42, v42, v45
    v_pk_sub_i16 v43, v43, v45
    v_pk_ashrrev_i16 v40, 15, v40 op_sel_hi:[0,1]
    v_pk_ashrrev_i16 v41, 15, v41 op_sel_hi:[0,1]
    v_pk_ashrrev_i16 v42, 15, v42 op_sel_hi:[0,1]
    v_pk_ashrrev_i16 v43, 15, v43 op_sel_hi:[0,1]
    v_bfi_b32 v48, v40, 0, v24
    v_bfi_b32 v49, v41, 0, v25
    v_bfi_b32 v50, v42, 0, v26
    v_bfi_b32 v51, v43, 0, v27
    s_waitcnt lgkmcnt(7)
    s_nop 1
    v_mfma_f32_32x32x16_bf16 v[96:111], v[48:51], v[84:87], v[96:111]
    ds_read_b128 v[80:83], v6 offset:8192
    s_waitcnt lgkmcnt(3)
    v_or_b32 v40, s45, v28
    v_or_b32 v41, s45, v29
    v_or_b32 v42, s45, v30
    v_or_b32 v43, s45, v31
    v_pk_max_u16 v44, v40, v41
    v_pk_max_u16 v45, v42, v43
    v_pk_min_u16 v46, v40, v41
    v_pk_min_u16 v47, v42, v43
    v_pk_min_u16 v44, v44, v44 op_sel:[0,1] op_sel_hi:[1,0]
    v_pk_min_u16 v45, v45, v45 op_sel:[0,1] op_sel_hi:[1,0]
    v_pk_max_u16 v46, v46, v46 op_sel:[0,1] op_sel_hi:[1,0]
    v_pk_max_u16 v47, v47, v47 op_sel:[0,1] op_sel_hi:[1,0]
    v_pk_max_u16 v44, v44, v46
    v_mfma_f32_32x32x16_bf16 v[112:127], v[48:51], v[88:91], v[112:127]
    ds_read_b128 v[84:87], v4 offset:12288
    v_pk_max_u16 v45, v45, v47
    v_pk_sub_i16 v40, v40, v44
    v_pk_sub_i16 v41, v41, v44
    v_pk_sub_i16 v42, v42, v45
    v_pk_sub_i16 v43, v43, v45
    v_pk_ashrrev_i16 v40, 15, v40 op_sel_hi:[0,1]
    v_pk_ashrrev_i16 v41, 15, v41 op_sel_hi:[0,1]
    v_pk_ashrrev_i16 v42, 15, v42 op_sel_hi:[0,1]
    v_pk_ashrrev_i16 v43, 15, v43 op_sel_hi:[0,1]
    v_bfi_b32 v52, v40, 0, v28
    v_bfi_b32 v53, v41, 0, v29
    v_bfi_b32 v54, v42, 0, v30
    v_bfi_b32 v55, v43, 0, v31
    s_nop 1
    v_mfma_f32_32x32x16_bf16 v[96:111], v[52:55], v[92:95], v[96:111]
    ds_read_b128 v[88:91], v5 offset:12288
    v_mfma_f32_32x32x16_bf16 v[112:127], v[52:55], v[56:59], v[112:127]
    ds_read_b128 v[92:95], v6 offset:12288
    v_mfma_f32_32x32x16_bf16 v[128:143], v[32:35], v[64:67], v[128:143]
    ds_read_b128 v[56:59], v4 offset:16384
    s_waitcnt lgkmcnt(6)
    v_mfma_f32_32x32x16_bf16 v[128:143], v[36:39], v[60:63], v[128:143]
    ds_read_b128 v[64:67], v5 offset:16384
    s_nop 3
    v_cvt_pk_bf16_f32 v96, v96, v97
    v_cvt_pk_bf16_f32 v97, v98, v99
    v_cvt_pk_bf16_f32 v98, v100, v101
    v_cvt_pk_bf16_f32 v99, v102, v103
    ds_write_b128 v20, v[96:99] offset:0
    v_cvt_pk_bf16_f32 v104, v104, v105
    s_waitcnt lgkmcnt(7)
    v_mfma_f32_32x32x16_bf16 v[128:143], v[48:51], v[76:79], v[128:143]
    ds_read_b128 v[60:63], v6 offset:16384
    v_cvt_pk_bf16_f32 v105, v106, v107
    v_cvt_pk_bf16_f32 v106, v108, v109
    v_cvt_pk_bf16_f32 v107, v110, v111
    ds_write_b128 v20, v[104:107] offset:32
    v_cvt_pk_bf16_f32 v112, v112, v113
    v_cvt_pk_bf16_f32 v113, v114, v115
    s_waitcnt lgkmcnt(8)
    v_mfma_f32_32x32x16_bf16 v[128:143], v[52:55], v[80:83], v[128:143]
    v_cvt_pk_bf16_f32 v114, v116, v117
    v_cvt_pk_bf16_f32 v115, v118, v119
    ds_write_b128 v20, v[112:115] offset:8704
    v_cvt_pk_bf16_f32 v120, v120, v121
    v_cvt_pk_bf16_f32 v121, v122, v123
    v_cvt_pk_bf16_f32 v122, v124, v125
    v_cvt_pk_bf16_f32 v123, v126, v127
    v_mfma_f32_32x32x16_bf16 v[144:159], v[32:35], v[68:71], v[144:159]
    ds_write_b128 v20, v[120:123] offset:8736
    v_mov_b32 v22, 1
    ds_write_b32 v21, v22
    v_mov_b32 v22, 2
    ds_write_b32 v21, v22
    s_waitcnt lgkmcnt(11)
    v_mfma_f32_32x32x16_bf16 v[144:159], v[36:39], v[84:87], v[144:159]
    s_waitcnt lgkmcnt(10)
    v_mfma_f32_32x32x16_bf16 v[144:159], v[48:51], v[88:91], v[144:159]
    v_cvt_pk_bf16_f32 v128, v128, v129
    v_cvt_pk_bf16_f32 v129, v130, v131
    v_cvt_pk_bf16_f32 v130, v132, v133
    v_cvt_pk_bf16_f32 v131, v134, v135
    ds_write_b128 v20, v[128:131] offset:17408
    v_cvt_pk_bf16_f32 v136, v136, v137
    s_waitcnt lgkmcnt(10)
    v_mfma_f32_32x32x16_bf16 v[144:159], v[52:55], v[92:95], v[144:159]
    v_cvt_pk_bf16_f32 v137, v138, v139
    v_cvt_pk_bf16_f32 v138, v140, v141
    v_cvt_pk_bf16_f32 v139, v142, v143
    ds_write_b128 v20, v[136:139] offset:17440
    v_mov_b32 v22, 3
    ds_write_b32 v21, v22
    v_mfma_f32_32x32x16_bf16 v[160:175], v[32:35], v[72:75], v[160:175]
    s_waitcnt lgkmcnt(11)
    v_mfma_f32_32x32x16_bf16 v[160:175], v[36:39], v[56:59], v[160:175]
    s_waitcnt lgkmcnt(10)
    v_mfma_f32_32x32x16_bf16 v[160:175], v[48:51], v[64:67], v[160:175]
    s_nop 0
    v_cvt_pk_bf16_f32 v144, v144, v145
    v_cvt_pk_bf16_f32 v145, v146, v147
    v_cvt_pk_bf16_f32 v146, v148, v149
    v_cvt_pk_bf16_f32 v147, v150, v151
    ds_write_b128 v23, v[144:147] offset:0
    v_cvt_pk_bf16_f32 v152, v152, v153
    s_waitcnt lgkmcnt(9)
    v_mfma_f32_32x32x16_bf16 v[160:175], v[52:55], v[60:63], v[160:175]
    v_cvt_pk_bf16_f32 v153, v154, v155
    v_cvt_pk_bf16_f32 v154, v156, v157
    v_cvt_pk_bf16_f32 v155, v158, v159
    ds_write_b128 v23, v[152:155] offset:32
    v_mov_b32 v22, 4
    ds_write_b32 v21, v22
    s_nop 3
    s_nop 4
    v_cvt_pk_bf16_f32 v160, v160, v161
    v_cvt_pk_bf16_f32 v161, v162, v163
    v_cvt_pk_bf16_f32 v162, v164, v165
    v_cvt_pk_bf16_f32 v163, v166, v167
    ds_write_b128 v23, v[160:163] offset:8704
    v_cvt_pk_bf16_f32 v168, v168, v169
    v_cvt_pk_bf16_f32 v169, v170, v171
    v_cvt_pk_bf16_f32 v170, v172, v173
    v_cvt_pk_bf16_f32 v171, v174, v175
    ds_write_b128 v23, v[168:171] offset:8736
    v_mov_b32 v22, 5
    ds_write_b32 v21, v22
    s_branch L_cend
L_c4_start:
    ds_read_b64_tr_b16 v[24:25], v16
    ds_read_b64_tr_b16 v[26:27], v16 offset:1024
    ds_read_b64_tr_b16 v[28:29], v17
    ds_read_b64_tr_b16 v[30:31], v17 offset:1024
    ds_read_b128 v[56:59], v3 offset:0
    ds_read_b128 v[60:63], v3 offset:4096
    ds_read_b128 v[64:67], v3 offset:8192
    ds_read_b128 v[68:71], v3 offset:12288
    s_waitcnt lgkmcnt(6)
    v_or_b32 v40, s45, v24
    v_or_b32 v41, s45, v25
    v_or_b32 v42, s45, v26
    v_or_b32 v43, s45, v27
    v_pk_max_u16 v44, v40, v41
    v_pk_max_u16 v45, v42, v43
    v_pk_min_u16 v46, v40, v41
    v_pk_min_u16 v47, v42, v43
    v_pk_min_u16 v44, v44, v44 op_sel:[0,1] op_sel_hi:[1,0]
    v_pk_min_u16 v45, v45, v45 op_sel:[0,1] op_sel_hi:[1,0]
    v_pk_max_u16 v46, v46, v46 op_sel:[0,1] op_sel_hi:[1,0]
    v_pk_max_u16 v47, v47, v47 op_sel:[0,1] op_sel_hi:[1,0]
    v_pk_max_u16 v44, v44, v46
    v_pk_max_u16 v45, v45, v47
    v_pk_sub_i16 v40, v40, v44
    v_pk_sub_i16 v41, v41, v44
    v_pk_sub_i16 v42, v42, v45
    v_pk_sub_i16 v43, v43, v45
    v_pk_ashrrev_i16 v40, 15, v40 op_sel_hi:[0,1]
    v_pk_ashrrev_i16 v41, 15, v41 op_sel_hi:[0,1]
    v_pk_ashrrev_i16 v42, 15, v42 op_sel_hi:[0,1]
    v_pk_ashrrev_i16 v43, 15, v43 op_sel_hi:[0,1]
    v_bfi_b32 v32, v40, 0, v24
    v_bfi_b32 v33, v41, 0, v25
    v_bfi_b32 v34, v42, 0, v26
    v_bfi_b32 v35, v43, 0, v27
L_c4_loop:
    s_waitcnt lgkmcnt(2)
    s_nop 0
    v_mfma_f32_32x32x16_bf16 v[96:111], v[32:35], v[56:59], v[96:111]
    ds_read_b64_tr_b16 v[24:25], v18
    ds_read_b64_tr_b16 v[26:27], v18 offset:1024
    ds_read_b128 v[76:79], v4 offset:0
    ds_read_b128 v[80:83], v4 offset:4096
    ds_read_b128 v[84:87], v4 offset:8192
    ds_read_b128 v[88:91], v4 offset:12288
    v_or_b32 v40, s45, v28
    v_or_b32 v41, s45, v29
    v_mfma_f32_32x32x16_bf16 v[112:127], v[32:35], v[60:63], v[112:127]
    v_or_b32 v42, s45, v30
    v_or_b32 v43, s45, v31
    v_pk_max_u16 v44, v40, v41
    v_pk_max_u16 v45, v42, v43
    v_pk_min_u16 v46, v40, v41
    v_pk_min_u16 v47, v42, v43
    v_pk_min_u16 v44, v44, v44 op_sel:[0,1] op_sel_hi:[1,0]
    v_pk_min_u16 v45, v45, v45 op_sel:[0,1] op_sel_hi:[1,0]
    s_waitcnt lgkmcnt(6)
    v_mfma_f32_32x32x16_bf16 v[128:143], v[32:35], v[64:67], v[128:143]
    v_pk_max_u16 v46, v46, v46 op_sel:[0,1] op_sel_hi:[1,0]
    v_pk_max_u16 v47, v47, v47 op_sel:[0,1] op_sel_hi:[1,0]
    v_pk_max_u16 v44, v44, v46
    v_pk_max_u16 v45, v45, v47
    v_pk_sub_i16 v40, v40, v44
    v_pk_sub_i16 v41, v41, v44
    v_pk_sub_i16 v42, v42, v45
    v_pk_sub_i16 v43, v43, v45
    v_mfma_f32_32x32x16_bf16 v[144:159], v[32:35], v[68:71], v[144:159]
    v_pk_ashrrev_i16 v40, 15, v40 op_sel_hi:[0,1]
    v_pk_ashrrev_i16 v41, 15, v41 op_sel_hi:[0,1]
    v_pk_ashrrev_i16 v42, 15, v42 op_sel_hi:[0,1]
    v_pk_ashrrev_i16 v43, 15, v43 op_sel_hi:[0,1]
    v_bfi_b32 v36, v40, 0, v28
    v_bfi_b32 v37, v41, 0, v29
    v_bfi_b32 v38, v42, 0, v30
    v_bfi_b32 v39, v43, 0, v31
    s_waitcnt lgkmcnt(2)
    s_nop 0
    v_mfma_f32_32x32x16_bf16 v[96:111], v[36:39], v[76:79], v[96:111]
    ds_read_b64_tr_b16 v[28:29], v19
    ds_read_b64_tr_b16 v[30:31], v19 offset:1024
    ds_read_b128 v[56:59], v5 offset:0
    ds_read_b128 v[60:63], v5 offset:4096
    ds_read_b128 v[64:67], v5 offset:8192
    ds_read_b128 v[68:71], v5 offset:12288
    v_or_b32 v40, s45, v24
    v_or_b32 v41, s45, v25
    v_mfma_f32_32x32x16_bf16 v[112:127], v[36:39], v[80:83], v[112:127]
    v_or_b32 v42, s45, v26
    v_or_b32 v43, s45, v27
    v_pk_max_u16 v44, v40, v41
    v_pk_max_u16 v45, v42, v43
    v_pk_min_u16 v46, v40, v41
    v_pk_min_u16 v47, v42, v43
    v_pk_min_u16 v44, v44, v44 op_sel:[0,1] op_sel_hi:[1,0]
    v_pk_min_u16 v45, v45, v45 op_sel:[0,1] op_sel_hi:[1,0]
    s_waitcnt lgkmcnt(6)
    v_mfma_f32_32x32x16_bf16 v[128:143], v[36:39], v[84:87], v[128:143]
    v_pk_max_u16 v46, v46, v46 op_sel:[0,1] op_sel_hi:[1,0]
    v_pk_max_u16 v47, v47, v47 op_sel:[0,1] op_sel_hi:[1,0]
    v_pk_max_u16 v44, v44, v46
    v_pk_max_u16 v45, v45, v47
    v_pk_sub_i16 v40, v40, v44
    v_pk_sub_i16 v41, v41, v44
    v_pk_sub_i16 v42, v42, v45
    v_pk_sub_i16 v43, v43, v45
    v_mfma_f32_32x32x16_bf16 v[144:159], v[36:39], v[88:91], v[144:159]
    v_pk_ashrrev_i16 v40, 15, v40 op_sel_hi:[0,1]
    v_pk_ashrrev_i16 v41, 15, v41 op_sel_hi:[0,1]
    v_pk_ashrrev_i16 v42, 15, v42 op_sel_hi:[0,1]
    v_pk_ashrrev_i16 v43, 15, v43 op_sel_hi:[0,1]
    v_bfi_b32 v32, v40, 0, v24
    v_bfi_b32 v33, v41, 0, v25
    v_bfi_b32 v34, v42, 0, v26
    v_bfi_b32 v35, v43, 0, v27
    s_waitcnt lgkmcnt(2)
    s_nop 0
    v_mfma_f32_32x32x16_bf16 v[96:111], v[32:35], v[56:59], v[96:111]
    s_add_u32 s56, s56, 1
    s_cmp_eq_u32 s56, 4
    s_cselect_b32 s58, s54, s39
    s_cselect_b32 s59, s55, s41
    s_cselect_b32 s56, 0, s56
    s_barrier
    v_add_u32 v16, s59, v16
    v_add_u32 v17, s59, v17
    v_add_u32 v18, s59, v18
    v_add_u32 v19, s59, v19
    ds_read_b64_tr_b16 v[24:25], v16
    ds_read_b64_tr_b16 v[26:27], v16 offset:1024
    ds_read_b128 v[76:79], v6 offset:0
    ds_read_b128 v[80:83], v6 offset:4096
    v_mfma_f32_32x32x16_bf16 v[112:127], v[32:35], v[60:63], v[112:127]
    ds_read_b128 v[84:87], v6 offset:8192
    ds_read_b128 v[88:91], v6 offset:12288
    v_or_b32 v40, s45, v28
    v_or_b32 v41, s45, v29
    v_or_b32 v42, s45, v30
    v_or_b32 v43, s45, v31
    v_pk_max_u16 v44, v40, v41
    v_pk_max_u16 v45, v42, v43
    v_pk_min_u16 v46, v40, v41
    s_waitcnt lgkmcnt(6)
    v_mfma_f32_32x32x16_bf16 v[128:143], v[32:35], v[64:67], v[128:143]
    v_pk_min_u16 v47, v42, v43
    v_pk_min_u16 v44, v44, v44 op_sel:[0,1] op_sel_hi:[1,0]
    v_pk_min_u16 v45, v45, v45 op_sel:[0,1] op_sel_hi:[1,0]
    v_pk_max_u16 v46, v46, v46 op_sel:[0,1] op_sel_hi:[1,0]
    v_pk_max_u16 v47, v47, v47 op_sel:[0,1] op_sel_hi:[1,0]
    v_pk_max_u16 v44, v44, v46
    v_pk_max_u16 v45, v45, v47
    v_pk_sub_i16 v40, v40, v44
    v_pk_sub_i16 v41, v41, v44
    v_pk_sub_i16 v42, v42, v45
    v_mfma_f32_32x32x16_bf16 v[144:159], v[32:35], v[68:71], v[144:159]
    v_pk_sub_i16 v43, v43, v45
    v_pk_ashrrev_i16 v40, 15, v40 op_sel_hi:[0,1]
    v_pk_ashrrev_i16 v41, 15, v41 op_sel_hi:[0,1]
    v_pk_ashrrev_i16 v42, 15, v42 op_sel_hi:[0,1]
    v_pk_ashrrev_i16 v43, 15, v43 op_sel_hi:[0,1]
    v_bfi_b32 v36, v40, 0, v28
    v_bfi_b32 v37, v41, 0, v29
    v_bfi_b32 v38, v42, 0, v30
    v_bfi_b32 v39, v43, 0, v31
    s_waitcnt lgkmcnt(2)
    s_nop 0
    v_mfma_f32_32x32x16_bf16 v[96:111], v[36:39], v[76:79], v[96:111]
    v_add_u32 v3, s58, v3
    v_add_u32 v4, s58, v4
    v_add_u32 v5, s58, v5
    v_add_u32 v6, s58, v6
    ds_read_b64_tr_b16 v[28:29], v17
    ds_read_b64_tr_b16 v[30:31], v17 offset:1024
    ds_read_b128 v[56:59], v3 offset:0
    ds_read_b128 v[60:63], v3 offset:4096
    ds_read_b128 v[64:67], v3 offset:8192
    v_mfma_f32_32x32x16_bf16 v[112:127], v[36:39], v[80:83], v[112:127]
    ds_read_b128 v[68:71], v3 offset:12288
    v_or_b32 v40, s45, v24
    v_or_b32 v41, s45, v25
    v_or_b32 v42, s45, v26
    v_or_b32 v43, s45, v27
    v_pk_max_u16 v44, v40, v41
    v_pk_max_u16 v45, v42, v43
    v_pk_min_u16 v46, v40, v41
    v_pk_min_u16 v47, v42, v43
    s_waitcnt lgkmcnt(6)
    v_mfma_f32_32x32x16_bf16 v[128:143], v[36:39], v[84:87], v[128:143]
    v_pk_min_u16 v44, v44, v44 op_sel:[0,1] op_sel_hi:[1,0]
    v_pk_min_u16 v45, v45, v45 op_sel:[0,1] op_sel_hi:[1,0]
    v_pk_max_u16 v46, v46, v46 op_sel:[0,1] op_sel_hi:[1,0]
    v_pk_max_u16 v47, v47, v47 op_sel:[0,1] op_sel_hi:[1,0]
    v_pk_max_u16 v44, v44, v46
    v_pk_max_u16 v45, v45, v47
    v_pk_sub_i16 v40, v40, v44
    v_pk_sub_i16 v41, v41, v44
    v_pk_sub_i16 v42, v42, v45
    v_mfma_f32_32x32x16_bf16 v[144:159], v[36:39], v[88:91], v[144:159]
    v_pk_sub_i16 v43, v43, v45
    v_pk_ashrrev_i16 v40, 15, v40 op_sel_hi:[0,1]
    v_pk_ashrrev_i16 v41, 15, v41 op_sel_hi:[0,1]
    v_pk_ashrrev_i16 v42, 15, v42 op_sel_hi:[0,1]
    v_pk_ashrrev_i16 v43, 15, v43 op_sel_hi:[0,1]
    v_bfi_b32 v32, v40, 0, v24
    v_bfi_b32 v33, v41, 0, v25
    v_bfi_b32 v34, v42, 0, v26
    v_bfi_b32 v35, v43, 0, v27
    s_add_u32 s50, s50, 1
    s_cmp_lt_u32 s50, 8
    s_cbranch_scc1 L_c4_loop
L_c4_p0:
    s_waitcnt lgkmcnt(3)
    v_mfma_f32_32x32x16_bf16 v[96:111], v[32:35], v[56:59], v[96:111]
    ds_read_b128 v[76:79], v4 offset:0
    ds_read_b128 v[80:83], v4 offset:4096
    ds_read_b64_tr_b16 v[24:25], v18
    ds_read_b64_tr_b16 v[26:27], v18 offset:1024
    v_or_b32 v40, s45, v28
    v_or_b32 v41, s45, v29
    v_or_b32 v42, s45, v30
    v_or_b32 v43, s45, v31
    v_pk_max_u16 v44, v40, v41
    v_pk_max_u16 v45, v42, v43
    v_pk_min_u16 v46, v40, v41
    v_pk_min_u16 v47, v42, v43
    v_pk_min_u16 v44, v44, v44 op_sel:[0,1] op_sel_hi:[1,0]
    v_pk_min_u16 v45, v45, v45 op_sel:[0,1] op_sel_hi:[1,0]
    v_pk_max_u16 v46, v46, v46 op_sel:[0,1] op_sel_hi:[1,0]
    v_pk_max_u16 v47, v47, v47 op_sel:[0,1] op_sel_hi:[1,0]
    s_waitcnt lgkmcnt(6)
    v_mfma_f32_32x32x16_bf16 v[112:127], v[32:35], v[60:63], v[112:127]
    ds_read_b128 v[84:87], v5 offset:0
    ds_read_b128 v[88:91], v5 offset:4096
    v_pk_max_u16 v44, v44, v46
    v_pk_max_u16 v45, v45, v47
    v_pk_sub_i16 v40, v40, v44
    v_pk_sub_i16 v41, v41, v44
    v_pk_sub_i16 v42, v42, v45
    v_pk_sub_i16 v43, v43, v45
    v_pk_ashrrev_i16 v40, 15, v40 op_sel_hi:[0,1]
    v_pk_ashrrev_i16 v41, 15, v41 op_sel_hi:[0,1]
    v_pk_ashrrev_i16 v42, 15, v42 op_sel_hi:[0,1]
    v_pk_ashrrev_i16 v43, 15, v43 op_sel_hi:[0,1]
    v_bfi_b32 v36, v40, 0, v28
    v_bfi_b32 v37, v41, 0, v29
    v_bfi_b32 v38, v42, 0, v30
    v_bfi_b32 v39, v43, 0, v31
    s_waitcnt lgkmcnt(5)
    s_nop 1
    v_mfma_f32_32x32x16_bf16 v[96:111], v[36:39], v[76:79], v[96:111]
    ds_read_b128 v[92:95], v6 offset:0
    ds_read_b128 v[56:59], v6 offset:4096
    ds_read_b64_tr_b16 v[28:29], v19
    ds_read_b64_tr_b16 v[30:31], v19 offset:1024
    s_waitcnt lgkmcnt(6)
    v_or_b32 v40, s45, v24
    v_or_b32 v41, s45, v25
    v_or_b32 v42, s45, v26
    v_or_b32 v43, s45, v27
    v_pk_max_u16 v44, v40, v41
    v_pk_max_u16 v45, v42, v43
    v_pk_min_u16 v46, v40, v41
    v_pk_min_u16 v47, v42, v43
    v_pk_min_u16 v44, v44, v44 op_sel:[0,1] op_sel_hi:[1,0]
    v_pk_min_u16 v45, v45, v45 op_sel:[0,1] op_sel_hi:[1,0]
    v_pk_max_u16 v46, v46, v46 op_sel:[0,1] op_sel_hi:[1,0]
    v_pk_max_u16 v47, v47, v47 op_sel:[0,1] op_sel_hi:[1,0]
    v_mfma_f32_32x32x16_bf16 v[112:127], v[36:39], v[80:83], v[112:127]
    ds_read_b128 v[60:63], v4 offset:8192
    ds_read_b128 v[76:79], v5 offset:8192
    v_pk_max_u16 v44, v44, v46
    v_pk_max_u16 v45, v45, v47
    v_pk_sub_i16 v40, v40, v44
    v_pk_sub_i16 v41, v41, v44
    v_pk_sub_i16 v42, v42, v45
    v_pk_sub_i16 v43, v43, v45
    v_pk_ashrrev_i16 v40, 15, v40 op_sel_hi:[0,1]
    v_pk_ashrrev_i16 v41, 15, v41 op_sel_hi:[0,1]
    v_pk_ashrrev_i16 v42, 15, v42 op_sel_hi:[0,1]
    v_pk_ashrrev_i16 v43, 15, v43 op_sel_hi:[0,1]
    v_bfi_b32 v48, v40, 0, v24
    v_bfi_b32 v49, v41, 0, v25
    v_bfi_b32 v50, v42, 0, v26
    v_bfi_b32 v51, v43, 0, v27
    s_waitcnt lgkmcnt(7)
    s_nop 1
    v_mfma_f32_32x32x16_bf16 v[96:111], v[48:51], v[84:87], v[96:111]
    ds_read_b128 v[80:83], v6 offset:8192
    s_waitcnt lgkmcnt(3)
    v_or_b32 v40, s45, v28
    v_or_b32 v41, s45, v29
    v_or_b32 v42, s45, v30
    v_or_b32 v43, s45, v31
    v_pk_max_u16 v44, v40, v41
    v_pk_max_u16 v45, v42, v43
    v_pk_min_u16 v46, v40, v41
    v_pk_min_u16 v47, v42, v43
    v_pk_min_u16 v44, v44, v44 op_sel:[0,1] op_sel_hi:[1,0]
    v_pk_min_u16 v45, v45, v45 op_sel:[0,1] op_sel_hi:[1,0]
    v_pk_max_u16 v46, v46, v46 op_sel:[0,1] op_sel_hi:[1,0]
    v_pk_max_u16 v47, v47, v47 op_sel:[0,1] op_sel_hi:[1,0]
    v_pk_max_u16 v44, v44, v46
    v_mfma_f32_32x32x16_bf16 v[112:127], v[48:51], v[88:91], v[112:127]
    ds_read_b128 v[84:87], v4 offset:12288
    v_pk_max_u16 v45, v45, v47
    v_pk_sub_i16 v40, v40, v44
    v_pk_sub_i16 v41, v41, v44
    v_pk_sub_i16 v42, v42, v45
    v_pk_sub_i16 v43, v43, v45
    v_pk_ashrrev_i16 v40, 15, v40 op_sel_hi:[0,1]
    v_pk_ashrrev_i16 v41, 15, v41 op_sel_hi:[0,1]
    v_pk_ashrrev_i16 v42, 15, v42 op_sel_hi:[0,1]
    v_pk_ashrrev_i16 v43, 15, v43 op_sel_hi:[0,1]
    v_bfi_b32 v52, v40, 0, v28
    v_bfi_b32 v53, v41, 0, v29
    v_bfi_b32 v54, v42, 0, v30
    v_bfi_b32 v55, v43, 0, v31
    s_nop 1
    v_mfma_f32_32x32x16_bf16 v[96:111], v[52:55], v[92:95], v[96:111]
    ds_read_b128 v[88:91], v5 offset:12288
    v_mfma_f32_32x32x16_bf16 v[112:127], v[52:55], v[56:59], v[112:127]
    ds_read_b128 v[92:95], v6 offset:12288
    v_mfma_f32_32x32x16_bf16 v[128:143], v[32:35], v[64:67], v[128:143]
    s_waitcnt lgkmcnt(5)
    v_mfma_f32_32x32x16_bf16 v[128:143], v[36:39], v[60:63], v[128:143]
    s_nop 5
    v_cvt_pk_bf16_f32 v96, v96, v97
    v_cvt_pk_bf16_f32 v97, v98, v99
    v_cvt_pk_bf16_f32 v98, v100, v101
    v_cvt_pk_bf16_f32 v99, v102, v103
    ds_write_b128 v20, v[96:99] offset:0
    v_cvt_pk_bf16_f32 v104, v104, v105
    s_waitcnt lgkmcnt(5)
    v_mfma_f32_32x32x16_bf16 v[128:143], v[48:51], v[76:79], v[128:143]
    v_cvt_pk_bf16_f32 v105, v106, v107
    v_cvt_pk_bf16_f32 v106, v108, v109
    v_cvt_pk_bf16_f32 v107, v110, v111
    ds_write_b128 v20, v[104:107] offset:32
    v_cvt_pk_bf16_f32 v112, v112, v113
    v_cvt_pk_bf16_f32 v113, v114, v115
    s_waitcnt lgkmcnt(5)
    v_mfma_f32_32x32x16_bf16 v[128:143], v[52:55], v[80:83], v[128:143]
    v_cvt_pk_bf16_f32 v114, v116, v117
    v_cvt_pk_bf16_f32 v115, v118, v119
    ds_write_b128 v20, v[112:115] offset:8704
    v_cvt_pk_bf16_f32 v120, v120, v121
    v_cvt_pk_bf16_f32 v121, v122, v123
    v_cvt_pk_bf16_f32 v122, v124, v125
    v_cvt_pk_bf16_f32 v123, v126, v127
    v_mfma_f32_32x32x16_bf16 v[144:159], v[32:35], v[68:71], v[144:159]
    ds_write_b128 v20, v[120:123] offset:8736
    v_mov_b32 v22, 1
    ds_write_b32 v21, v22
    v_mov_b32 v22, 2
    ds_write_b32 v21, v22
    s_waitcnt lgkmcnt(8)
    v_mfma_f32_32x32x16_bf16 v[144:159], v[36:39], v[84:87], v[144:159]
    s_waitcnt lgkmcnt(7)
    v_mfma_f32_32x32x16_bf16 v[144:159], v[48:51], v[88:91], v[144:159]
    v_cvt_pk_bf16_f32 v128, v128, v129
    v_cvt_pk_bf16_f32 v129, v130, v131
    v_cvt_pk_bf16_f32 v130, v132, v133
    v_cvt_pk_bf16_f32 v131, v134, v135
    ds_write_b128 v20, v[128:131] offset:17408
    v_cvt_pk_bf16_f32 v136, v136, v137
    s_waitcnt lgkmcnt(7)
    v_mfma_f32_32x32x16_bf16 v[144:159], v[52:55], v[92:95], v[144:159]
    v_cvt_pk_bf16_f32 v137, v138, v139
    v_cvt_pk_bf16_f32 v138, v140, v141
    v_cvt_pk_bf16_f32 v139, v142, v143
    ds_write_b128 v20, v[136:139] offset:17440
    v_mov_b32 v22, 3
    ds_write_b32 v21, v22
    s_nop 3
    s_nop 4
    v_cvt_pk_bf16_f32 v144, v144, v145
    v_cvt_pk_bf16_f32 v145, v146, v147
    v_cvt_pk_bf16_f32 v146, v148, v149
    v_cvt_pk_bf16_f32 v147, v150, v151
    ds_write_b128 v23, v[144:147] offset:0
    v_cvt_pk_bf16_f32 v152, v152, v153
    v_cvt_pk_bf16_f32 v153, v154, v155
    v_cvt_pk_bf16_f32 v154, v156, v157
    v_cvt_pk_bf16_f32 v155, v158, v159
    ds_write_b128 v23, v[152:155] offset:32
    v_mov_b32 v22, 4
    ds_write_b32 v21, v22
    s_branch L_cend
L_cend:
L_exit:
    s_endpgm
.section .rodata,"a"
.p2align 6
.amdhsa_kernel standalone__structured_sparse_n_m__ragged_kernel
  .amdhsa_next_free_vgpr 176
  .amdhsa_next_free_sgpr 96
  .amdhsa_accum_offset 176
  .amdhsa_group_segment_fixed_size 0
  .amdhsa_kernarg_size 48
  .amdhsa_user_sgpr_count 2
  .amdhsa_user_sgpr_kernarg_segment_ptr 1
  .amdhsa_system_sgpr_workgroup_id_x 1
.end_amdhsa_kernel
```
